```python
import torch

def _softmax(x, axis=-1):
    return torch.softmax(x, dim=axis)
def _gelu(x):
    return torch.nn.functional.gelu(x, approximate="tanh")
def _silu(x):
    return torch.nn.functional.silu(x)
def _sigmoid(x):
    return torch.sigmoid(x)
def _layernorm(x, axis=-1, eps=1e-5):
    m = x.mean(dim=axis, keepdim=True)
    v = x.var(dim=axis, keepdim=True, unbiased=False)
    return (x - m) / torch.sqrt(v + eps)
def _scatter_add(tgt, idx, src, axis=0):
    return tgt.clone().index_add_(axis, idx, src)
def _segment_sum(src, seg, n):
    out = torch.zeros((n,) + src.shape[1:], dtype=src.dtype)
    return out.index_add_(0, seg, src)
def _pad(x, pw):
    flat = tuple(v for pair in reversed(pw) for v in pair)
    return torch.nn.functional.pad(x, flat)

kernel_name = 'interleave_layers__sliding_block_cached__mixer_token_mlp__decode'

def setup_inputs():

    _w = (lambda a: (lambda t: t.to(torch.bfloat16) if t.is_floating_point() else t)(torch.as_tensor(a)))
    def _A_setup():
        B, Sq, D = 1, 1, 512
        Hq, Hkv, Sk, Dh = 32, 8, 65536, 128
        assert Hq % Hkv == 0, (Hq, Hkv)
        return {
            "x": _w((lambda *s: torch.randn(*s, dtype=torch.bfloat16) * 0.05)(B, Sq, D)),
            "k_cache": _w((lambda *s: torch.randn(*s, dtype=torch.bfloat16) * 0.8)(B, Hkv, Sk, Dh)),
            "v_cache": _w((lambda *s: torch.randn(*s, dtype=torch.bfloat16) * 1.6)(B, Hkv, Sk, Dh)),
            "wq": _w((lambda *s: torch.randn(*s, dtype=torch.bfloat16) * 0.8)(D, Hq * Dh) * (D ** -0.5)),
            "wo": _w((lambda *s: torch.randn(*s, dtype=torch.bfloat16) * 1.6)(Hq * Dh, D) * ((Hq * Dh) ** -0.5)),
        }
    _A_in = _A_setup()

    def _B_setup():
        B, S, D, F = 1, 1, 512, 1792
        return {
            "x": _w((lambda *s: torch.randn(*s, dtype=torch.bfloat16) * 0.05)(B, S, D)),
            "w1": _w((lambda *s: torch.randn(*s, dtype=torch.bfloat16) * 0.8)(S, F) * (S ** -0.5)),
            "b1": _w((lambda *s: torch.randn(*s, dtype=torch.bfloat16) * 0.2)(F) * 0.02),
            "w2": _w((lambda *s: torch.randn(*s, dtype=torch.bfloat16) * 0.2)(F, S) * (F ** -0.5)),
            "b2": _w((lambda *s: torch.randn(*s, dtype=torch.bfloat16) * 0.2)(S) * 0.02),
        }
    _B_in = _B_setup()

    return {
        "A_x": _A_in["x"],
        "A_k_cache": _A_in["k_cache"],
        "A_v_cache": _A_in["v_cache"],
        "A_wq": _A_in["wq"],
        "A_wo": _A_in["wo"],
        "B_x": _B_in["x"],
        "B_w1": _B_in["w1"],
        "B_b1": _B_in["b1"],
        "B_w2": _B_in["w2"],
        "B_b2": _B_in["b2"],
    }

def reference(A_x, A_k_cache, A_v_cache, A_wq, A_wo, B_x, B_w1, B_b1, B_w2, B_b2):
    def _A_ref(x, k_cache, v_cache, wq, wo):
        B, Sq, D = x.shape
        Hq, Dh = 32, 128
        Hkv, Sk = k_cache.shape[1], k_cache.shape[2]
        W = min(4096, max(256, Sk // 4))
        rep = Hq // Hkv
        q = (lambda x, *d: x.permute(*d))((x @ wq).reshape(B, Sq, Hq, Dh), 0, 2, 1, 3)
        k = (lambda x, n, axis: torch.repeat_interleave(x, n, dim=axis))(k_cache[:, :, Sk - W:, :], rep, axis=1)
        v = (lambda x, n, axis: torch.repeat_interleave(x, n, dim=axis))(v_cache[:, :, Sk - W:, :], rep, axis=1)
        scores = torch.einsum("bhqd,bhkd->bhqk", q, k) * (Dh ** -0.5)
        p = _softmax(scores, axis=-1)
        o = torch.einsum("bhqk,bhkd->bhqd", p, v)
        return (lambda x, *d: x.permute(*d))(o, 0, 2, 1, 3).reshape(B, Sq, Hq * Dh) @ wo

    def _B_ref(x, w1, b1, w2, b2):
        B, S, D = x.shape
        h = _layernorm(x, axis=-1)
        u = torch.einsum("bsd,sf->bdf", h, w1) + b1
        u = _gelu(u)
        y = torch.einsum("bdf,fs->bds", u, w2) + b2
        return (lambda x, *d: x.permute(*d))(y, 0, 2, 1)

    x = A_x
    x = x + _A_ref(_layernorm(x, axis=-1), A_k_cache, A_v_cache, A_wq, A_wo)
    x = x + _B_ref(_layernorm(x, axis=-1), B_w1, B_b1, B_w2, B_b2)
    x = x + _A_ref(_layernorm(x, axis=-1), A_k_cache, A_v_cache, A_wq, A_wo)
    x = x + _B_ref(_layernorm(x, axis=-1), B_w1, B_b1, B_w2, B_b2)
    return x
```

```asm
; @launch grid=(256,1,1) block=(512,1,1) lds=98304
.amdgcn_target "amdgcn-amd-amdhsa--gfx950"
.text
.globl interleave_layers__sliding_block_cached__mixer_token_mlp__decode_kernel
.p2align 8
.type interleave_layers__sliding_block_cached__mixer_token_mlp__decode_kernel,@function
interleave_layers__sliding_block_cached__mixer_token_mlp__decode_kernel:
  s_cmp_ge_u32 s2, 256
  s_cbranch_scc1 END
  s_load_dwordx16 s[16:31], s[0:1], 0
  s_load_dwordx8 s[32:39], s[0:1], 64
  s_load_dwordx2 s[40:41], s[0:1], 96
  v_and_b32 v1, 63, v0
  v_lshrrev_b32 v2, 6, v0
  s_and_b32 s5, s2, 7
  s_lshr_b32 s6, s2, 3
  v_readfirstlane_b32 s4, v2
  v_lshlrev_b32 v185, 4, v1
  v_lshlrev_b32 v187, 5, v1
  s_mov_b32 s42, 0
  s_and_b32 s95, s6, 7
  s_lshr_b32 s88, s6, 3
  s_mov_b32 s43, s2
  s_mov_b32 s44, 0x3fb8aa3b
  s_mov_b32 s46, 0x3db504f3
  s_mov_b32 s48, 0xc0135761
  s_mov_b32 s50, 0xbdd2d3e8
  s_waitcnt lgkmcnt(0)
  s_cmp_ge_u32 s4, 4
  s_cbranch_scc1 LOADER
  s_load_dword s7, s[40:41], 0
  s_cmp_lg_u32 s4, 0
  s_cbranch_scc1 NOX
  global_load_dwordx4 v[200:203], v185, s[16:17]
NOX:
  s_lshl_b32 s8, s5, 24
  s_lshl_b32 s9, s6, 15
  s_add_u32 s8, s8, s9
  s_lshl_b32 s9, s4, 13
  s_add_u32 s8, s8, s9
  s_add_u32 s8, s8, 0xf00000
  v_and_b32 v3, 15, v1
  v_lshrrev_b32 v4, 4, v1
  v_lshlrev_b32 v2, 8, v3
  v_lshl_add_u32 v2, v4, 4, v2
  v_add_u32 v2, s8, v2
  v_add_u32 v5, 0x1000, v2
  global_load_dwordx4 v[48:51], v2, s[18:19] offset:0 nt
  global_load_dwordx4 v[52:55], v2, s[18:19] offset:64 nt
  global_load_dwordx4 v[56:59], v2, s[18:19] offset:128 nt
  global_load_dwordx4 v[60:63], v2, s[18:19] offset:192 nt
  global_load_dwordx4 v[64:67], v5, s[18:19] offset:0 nt
  global_load_dwordx4 v[68:71], v5, s[18:19] offset:64 nt
  global_load_dwordx4 v[72:75], v5, s[18:19] offset:128 nt
  global_load_dwordx4 v[76:79], v5, s[18:19] offset:192 nt
  v_mov_b32 v6, 0
  global_load_ushort v168, v6, s[34:35]
  s_lshl_b32 s8, s43, 2
  v_mov_b32 v6, s8
  global_load_dword v170, v6, s[16:17]
  s_lshl_b32 s8, s5, 14
  s_lshl_b32 s9, s4, 10
  s_add_u32 s8, s8, s9
  s_add_u32 s8, s8, 0x40000
  v_add_u32 v172, s8, v185
  s_lshl_b32 s8, s5, 14
  s_lshl_b32 s9, s88, 12
  s_add_u32 s8, s8, s9
  s_lshl_b32 s9, s95, 9
  s_add_u32 s8, s8, s9
  s_lshl_b32 s9, s4, 7
  s_add_u32 s8, s8, s9
  s_add_u32 s8, s8, 0x40000
  v_add_u32 v181, s8, v187
  v_lshrrev_b32 v6, 2, v3
  v_lshlrev_b32 v6, 8, v6
  v_lshl_add_u32 v6, v4, 4, v6
  v_add_u32 v186, 0xec00, v6
  s_lshl_b32 s8, s5, 17
  s_lshl_b32 s9, s6, 12
  s_add_u32 s8, s8, s9
  s_add_u32 s8, s8, 0x100000
  v_lshlrev_b32 v6, 4, v0
  v_add_u32 v173, s8, v6
  s_lshl_b32 s8, s5, 17
  s_lshl_b32 s9, s6, 12
  s_add_u32 s8, s8, s9
  s_add_u32 s8, s8, 0x200000
  v_add_u32 v177, s8, v6
  s_lshl_b32 s8, s5, 11
  s_lshl_b32 s9, s6, 6
  s_add_u32 s8, s8, s9
  s_lshl_b32 s9, s4, 4
  s_add_u32 s8, s8, s9
  s_add_u32 s8, s8, 0x8000
  v_mov_b32 v174, s8
  s_lshr_b32 s10, s6, 3
  s_lshl_b32 s8, s5, 11
  s_lshl_b32 s9, s10, 4
  s_add_u32 s8, s8, s9
  s_add_u32 s8, s8, 0x8000
  v_lshrrev_b32 v6, 1, v1
  v_lshlrev_b32 v7, 6, v6
  v_add_u32 v175, s8, v7
  s_lshl_b32 s8, s5, 17
  s_lshl_b32 s9, s6, 7
  s_add_u32 s8, s8, s9
  s_lshl_b32 s9, s4, 5
  s_add_u32 s8, s8, s9
  s_add_u32 s8, s8, 0x100000
  v_lshlrev_b32 v7, 12, v6
  v_and_b32 v6, 1, v1
  v_lshl_add_u32 v7, v6, 4, v7
  v_add_u32 v176, s8, v7
  s_lshl_b32 s8, s5, 17
  s_lshl_b32 s9, s6, 7
  s_add_u32 s8, s8, s9
  s_add_u32 s8, s8, 0x200000
  v_lshrrev_b32 v6, 3, v1
  v_lshlrev_b32 v7, 12, v6
  v_and_b32 v8, 7, v1
  v_lshl_add_u32 v7, v8, 4, v7
  v_add_u32 v178, s8, v7
  s_lshl_b32 s8, s6, 10
  s_lshl_b32 s9, s5, 7
  s_add_u32 s8, s8, s9
  s_add_u32 s8, s8, 0x300000
  v_lshlrev_b32 v7, 15, v6
  v_lshl_add_u32 v7, v8, 4, v7
  v_add_u32 v190, s8, v7
  s_lshl_b32 s8, s5, 15
  s_lshl_b32 s9, s6, 10
  s_add_u32 s8, s8, s9
  s_add_u32 s8, s8, 0x300000
  v_add_u32 v191, s8, v185
  s_lshl_b32 s8, s5, 11
  s_lshl_b32 s9, s6, 6
  s_add_u32 s8, s8, s9
  s_add_u32 s8, s8, 0x10000
  v_lshlrev_b32 v7, 3, v8
  v_add_u32 v240, s8, v7
  s_lshl_b32 s8, s6, 6
  s_add_u32 s8, s8, 0x17800
  v_add_u32 v241, s8, v7
  s_lshl_b32 s8, s5, 11
  s_add_u32 s8, s8, 0x10000
  v_add_u32 v179, s8, v187
  s_lshl_b32 s8, s43, 3
  s_add_u32 s8, s8, 0x10000
  v_lshlrev_b32 v6, 11, v1
  v_add_u32 v180, s8, v6
  v_lshrrev_b32 v6, 2, v3
  v_lshl_add_u32 v6, v4, 2, v6
  v_lshlrev_b32 v7, 8, v6
  v_and_b32 v6, 7, v6
  v_lshl_add_u32 v7, v6, 5, v7
  v_and_b32 v6, 3, v1
  v_lshl_add_u32 v7, v6, 3, v7
  s_lshl_b32 s8, s4, 13
  v_add_u32 v182, s8, v7
  s_lshl_b32 s8, s4, 11
  s_add_u32 s8, s8, 0xf800
  v_lshlrev_b32 v6, 2, v3
  v_lshl_add_u32 v6, v4, 9, v6
  v_add_u32 v183, s8, v6
  s_lshl_b32 s8, s4, 9
  s_add_u32 s8, s8, 0xf800
  v_lshlrev_b32 v6, 3, v1
  v_add_u32 v184, s8, v6
  s_add_u32 s90, s40, 0x400000
  s_addc_u32 s91, s41, 0
  s_waitcnt lgkmcnt(0)
  s_add_u32 s7, s7, 1
LAYER:
  s_lshl_b32 s94, s42, 3
  s_cmp_lg_u32 s4, 0
  s_cbranch_scc1 QW
  s_cmp_lg_u32 s42, 0
  s_cbranch_scc1 QPOLL
  s_waitcnt vmcnt(10)
  v_lshlrev_b32 v192, 16, v200
  v_and_b32 v193, 0xffff0000, v200
  v_lshlrev_b32 v194, 16, v201
  v_and_b32 v195, 0xffff0000, v201
  v_lshlrev_b32 v196, 16, v202
  v_and_b32 v197, 0xffff0000, v202
  v_lshlrev_b32 v198, 16, v203
  v_and_b32 v199, 0xffff0000, v203
  s_branch QLN
QPOLL:
  v_add_u32 v6, 0x10000, v179
  s_sub_u32 s7, s7, 1
  s_mov_b32 s12, 0x100000
POLL0:
  global_load_dwordx4 v[200:203], v6, s[40:41] sc1
  global_load_dwordx4 v[204:207], v6, s[40:41] offset:16 sc1
  s_waitcnt vmcnt(0)
  v_min3_u32 v208, v201, v203, v205
  v_max3_u32 v209, v201, v203, v205
  v_min_u32 v208, v208, v207
  v_max_u32 v209, v209, v207
  v_cmp_ne_u32 vcc, s7, v208
  v_cmp_ne_u32 s[8:9], s7, v209
  s_nop 0
  s_or_b64 vcc, vcc, s[8:9]
  s_cmp_eq_u64 vcc, 0
  s_cbranch_scc1 POLLX0
  s_sub_u32 s12, s12, 1
  s_cbranch_scc0 POLL0
POLLX0:
  s_add_u32 s7, s7, 1
  v_lshlrev_b32 v192, 16, v200
  v_and_b32 v193, 0xffff0000, v200
  v_lshlrev_b32 v194, 16, v202
  v_and_b32 v195, 0xffff0000, v202
  v_lshlrev_b32 v196, 16, v204
  v_and_b32 v197, 0xffff0000, v204
  v_lshlrev_b32 v198, 16, v206
  v_and_b32 v199, 0xffff0000, v206
QLN:
  v_add_u32 v6, 0x17800, v187
  ds_write_b128 v6, v[192:195]
  ds_write_b128 v6, v[196:199] offset:16
  s_nop 0
  v_readfirstlane_b32 s52, v192
  s_nop 0
  s_xor_b32 s54, s52, 0x80000000
  s_nop 0
  v_pk_add_f32 v[208:209], v[192:193], s[54:55] op_sel_hi:[1,0]
  v_pk_mul_f32 v[210:211], v[208:209], v[208:209]
  v_pk_add_f32 v[212:213], v[194:195], s[54:55] op_sel_hi:[1,0]
  v_pk_add_f32 v[208:209], v[208:209], v[212:213]
  v_pk_fma_f32 v[210:211], v[212:213], v[212:213], v[210:211]
  v_pk_add_f32 v[212:213], v[196:197], s[54:55] op_sel_hi:[1,0]
  v_pk_add_f32 v[208:209], v[208:209], v[212:213]
  v_pk_fma_f32 v[210:211], v[212:213], v[212:213], v[210:211]
  v_pk_add_f32 v[212:213], v[198:199], s[54:55] op_sel_hi:[1,0]
  v_pk_add_f32 v[208:209], v[208:209], v[212:213]
  v_pk_fma_f32 v[210:211], v[212:213], v[212:213], v[210:211]
  v_add_f32 v208, v208, v209
  v_add_f32 v210, v210, v211
  s_nop 1
  v_add_f32_dpp v208, v208, v208 row_ror:1 row_mask:0xf bank_mask:0xf
  v_add_f32_dpp v210, v210, v210 row_ror:1 row_mask:0xf bank_mask:0xf
  s_nop 0
  v_add_f32_dpp v208, v208, v208 row_ror:2 row_mask:0xf bank_mask:0xf
  v_add_f32_dpp v210, v210, v210 row_ror:2 row_mask:0xf bank_mask:0xf
  s_nop 0
  v_add_f32_dpp v208, v208, v208 row_ror:4 row_mask:0xf bank_mask:0xf
  v_add_f32_dpp v210, v210, v210 row_ror:4 row_mask:0xf bank_mask:0xf
  s_nop 0
  v_add_f32_dpp v208, v208, v208 row_ror:8 row_mask:0xf bank_mask:0xf
  v_add_f32_dpp v210, v210, v210 row_ror:8 row_mask:0xf bank_mask:0xf
  v_mov_b32 v215, v208
  v_mov_b32 v217, v210
  s_nop 0
  v_permlane16_swap_b32 v208, v215
  v_permlane16_swap_b32 v210, v217
  v_add_f32 v208, v208, v215
  v_add_f32 v210, v210, v217
  v_mov_b32 v215, v208
  v_mov_b32 v217, v210
  s_nop 0
  v_permlane32_swap_b32 v208, v215
  v_permlane32_swap_b32 v210, v217
  v_add_f32 v208, v208, v215
  v_add_f32 v210, v210, v217
  v_mul_f32 v208, 0x3b000000, v208
  v_mul_f32 v210, 0x3b000000, v210
  v_fma_f32 v210, -v208, v208, v210
  v_max_f32 v210, 0, v210
  v_add_f32 v214, s52, v208
  v_cvt_pk_bf16_f32 v215, v214, v210
  v_lshlrev_b32 v214, 16, v215
  v_and_b32 v210, 0xffff0000, v215
  v_add_f32 v210, 0x3727c5ac, v210
  v_cvt_pk_bf16_f32 v215, v210, v210
  v_lshlrev_b32 v210, 16, v215
  v_sqrt_f32 v210, v210
  v_xor_b32 v214, 0x80000000, v214
  v_cvt_pk_bf16_f32 v215, v210, v210
  v_lshlrev_b32 v210, 16, v215
  v_rcp_f32 v216, v210
  v_pk_add_f32 v[192:193], v[192:193], v[214:215] op_sel_hi:[1,0]
  v_cvt_pk_bf16_f32 v215, v192, v193
  v_lshlrev_b32 v192, 16, v215
  v_and_b32 v193, 0xffff0000, v215
  v_pk_mul_f32 v[192:193], v[192:193], v[216:217] op_sel_hi:[1,0]
  v_cvt_pk_bf16_f32 v215, v192, v193
  v_lshlrev_b32 v192, 16, v215
  v_and_b32 v193, 0xffff0000, v215
  v_pk_add_f32 v[194:195], v[194:195], v[214:215] op_sel_hi:[1,0]
  v_cvt_pk_bf16_f32 v215, v194, v195
  v_lshlrev_b32 v194, 16, v215
  v_and_b32 v195, 0xffff0000, v215
  v_pk_mul_f32 v[194:195], v[194:195], v[216:217] op_sel_hi:[1,0]
  v_cvt_pk_bf16_f32 v215, v194, v195
  v_lshlrev_b32 v194, 16, v215
  v_and_b32 v195, 0xffff0000, v215
  v_pk_add_f32 v[196:197], v[196:197], v[214:215] op_sel_hi:[1,0]
  v_cvt_pk_bf16_f32 v215, v196, v197
  v_lshlrev_b32 v196, 16, v215
  v_and_b32 v197, 0xffff0000, v215
  v_pk_mul_f32 v[196:197], v[196:197], v[216:217] op_sel_hi:[1,0]
  v_cvt_pk_bf16_f32 v215, v196, v197
  v_lshlrev_b32 v196, 16, v215
  v_and_b32 v197, 0xffff0000, v215
  v_pk_add_f32 v[198:199], v[198:199], v[214:215] op_sel_hi:[1,0]
  v_cvt_pk_bf16_f32 v215, v198, v199
  v_lshlrev_b32 v198, 16, v215
  v_and_b32 v199, 0xffff0000, v215
  v_pk_mul_f32 v[198:199], v[198:199], v[216:217] op_sel_hi:[1,0]
  v_cvt_pk_bf16_f32 v215, v198, v199
  v_lshlrev_b32 v198, 16, v215
  v_and_b32 v199, 0xffff0000, v215
  v_add_u32 v6, 0xf000, v187
  ds_write_b128 v6, v[192:195]
  ds_write_b128 v6, v[196:199] offset:16
  s_waitcnt lgkmcnt(0)
QW:
  s_lshl_b32 s8, s88, 9
  s_add_u32 s8, s8, 0xf000
  v_lshrrev_b32 v6, 2, v1
  v_lshlrev_b32 v6, 5, v6
  v_add_u32 v6, s8, v6
  s_barrier
  ds_read_b128 v[192:195], v6
  ds_read_b128 v[196:199], v6 offset:16
QG:
  s_cmp_lg_u32 s42, 0
  s_cbranch_scc1 QG2
  s_lshl_b32 s8, s4, 5
  s_add_u32 s8, s8, 0x13800
  v_lshrrev_b32 v6, 2, v1
  v_lshlrev_b32 v6, 10, v6
  v_and_b32 v7, 3, v1
  v_lshl_add_u32 v6, v7, 3, v6
  v_add_u32 v6, s8, v6
  ds_read_b64 v[208:209], v6 offset:0
  ds_read_b64 v[210:211], v6 offset:128
  ds_read_b64 v[212:213], v6 offset:256
  ds_read_b64 v[214:215], v6 offset:384
  ds_read_b64 v[216:217], v6 offset:512
  ds_read_b64 v[218:219], v6 offset:640
  ds_read_b64 v[220:221], v6 offset:768
  ds_read_b64 v[222:223], v6 offset:896
  s_waitcnt lgkmcnt(0)
  v_lshlrev_b32 v16, 16, v208
  v_and_b32 v17, 0xffff0000, v208
  v_lshlrev_b32 v18, 16, v209
  v_and_b32 v19, 0xffff0000, v209
  v_lshlrev_b32 v20, 16, v210
  v_and_b32 v21, 0xffff0000, v210
  v_lshlrev_b32 v22, 16, v211
  v_and_b32 v23, 0xffff0000, v211
  v_lshlrev_b32 v24, 16, v212
  v_and_b32 v25, 0xffff0000, v212
  v_lshlrev_b32 v26, 16, v213
  v_and_b32 v27, 0xffff0000, v213
  v_lshlrev_b32 v28, 16, v214
  v_and_b32 v29, 0xffff0000, v214
  v_lshlrev_b32 v30, 16, v215
  v_and_b32 v31, 0xffff0000, v215
  v_lshlrev_b32 v32, 16, v216
  v_and_b32 v33, 0xffff0000, v216
  v_lshlrev_b32 v34, 16, v217
  v_and_b32 v35, 0xffff0000, v217
  v_lshlrev_b32 v36, 16, v218
  v_and_b32 v37, 0xffff0000, v218
  v_lshlrev_b32 v38, 16, v219
  v_and_b32 v39, 0xffff0000, v219
  v_lshlrev_b32 v40, 16, v220
  v_and_b32 v41, 0xffff0000, v220
  v_lshlrev_b32 v42, 16, v221
  v_and_b32 v43, 0xffff0000, v221
  v_lshlrev_b32 v44, 16, v222
  v_and_b32 v45, 0xffff0000, v222
  v_lshlrev_b32 v46, 16, v223
  v_and_b32 v47, 0xffff0000, v223
QG2:
  s_waitcnt lgkmcnt(0)
  v_pk_mul_f32 v[224:225], v[192:193], v[16:17] op_sel:[0,0] op_sel_hi:[0,1]
  v_pk_mul_f32 v[226:227], v[192:193], v[18:19] op_sel:[0,0] op_sel_hi:[0,1]
  v_pk_fma_f32 v[224:225], v[192:193], v[20:21], v[224:225] op_sel:[1,0,0] op_sel_hi:[1,1,1]
  v_pk_fma_f32 v[226:227], v[192:193], v[22:23], v[226:227] op_sel:[1,0,0] op_sel_hi:[1,1,1]
  v_pk_fma_f32 v[224:225], v[194:195], v[24:25], v[224:225] op_sel:[0,0,0] op_sel_hi:[0,1,1]
  v_pk_fma_f32 v[226:227], v[194:195], v[26:27], v[226:227] op_sel:[0,0,0] op_sel_hi:[0,1,1]
  v_pk_fma_f32 v[224:225], v[194:195], v[28:29], v[224:225] op_sel:[1,0,0] op_sel_hi:[1,1,1]
  v_pk_fma_f32 v[226:227], v[194:195], v[30:31], v[226:227] op_sel:[1,0,0] op_sel_hi:[1,1,1]
  v_pk_fma_f32 v[224:225], v[196:197], v[32:33], v[224:225] op_sel:[0,0,0] op_sel_hi:[0,1,1]
  v_pk_fma_f32 v[226:227], v[196:197], v[34:35], v[226:227] op_sel:[0,0,0] op_sel_hi:[0,1,1]
  v_pk_fma_f32 v[224:225], v[196:197], v[36:37], v[224:225] op_sel:[1,0,0] op_sel_hi:[1,1,1]
  v_pk_fma_f32 v[226:227], v[196:197], v[38:39], v[226:227] op_sel:[1,0,0] op_sel_hi:[1,1,1]
  v_pk_fma_f32 v[224:225], v[198:199], v[40:41], v[224:225] op_sel:[0,0,0] op_sel_hi:[0,1,1]
  v_pk_fma_f32 v[226:227], v[198:199], v[42:43], v[226:227] op_sel:[0,0,0] op_sel_hi:[0,1,1]
  v_pk_fma_f32 v[224:225], v[198:199], v[44:45], v[224:225] op_sel:[1,0,0] op_sel_hi:[1,1,1]
  v_pk_fma_f32 v[226:227], v[198:199], v[46:47], v[226:227] op_sel:[1,0,0] op_sel_hi:[1,1,1]
  s_nop 1
  v_add_f32_dpp v224, v224, v224 row_ror:4 row_mask:0xf bank_mask:0xf
  v_add_f32_dpp v225, v225, v225 row_ror:4 row_mask:0xf bank_mask:0xf
  v_add_f32_dpp v226, v226, v226 row_ror:4 row_mask:0xf bank_mask:0xf
  v_add_f32_dpp v227, v227, v227 row_ror:4 row_mask:0xf bank_mask:0xf
  v_add_f32_dpp v224, v224, v224 row_ror:8 row_mask:0xf bank_mask:0xf
  v_add_f32_dpp v225, v225, v225 row_ror:8 row_mask:0xf bank_mask:0xf
  v_add_f32_dpp v226, v226, v226 row_ror:8 row_mask:0xf bank_mask:0xf
  v_add_f32_dpp v227, v227, v227 row_ror:8 row_mask:0xf bank_mask:0xf
  v_mov_b32 v228, v224
  v_mov_b32 v229, v225
  v_mov_b32 v230, v226
  v_mov_b32 v231, v227
  v_permlane16_swap_b32 v224, v228
  v_permlane16_swap_b32 v225, v229
  v_permlane16_swap_b32 v226, v230
  v_permlane16_swap_b32 v227, v231
  v_add_f32 v224, v224, v228
  v_add_f32 v225, v225, v229
  v_add_f32 v226, v226, v230
  v_add_f32 v227, v227, v231
  v_mov_b32 v228, v224
  v_mov_b32 v229, v225
  v_mov_b32 v230, v226
  v_mov_b32 v231, v227
  v_permlane32_swap_b32 v224, v228
  v_permlane32_swap_b32 v225, v229
  v_permlane32_swap_b32 v226, v230
  v_permlane32_swap_b32 v227, v231
  v_add_f32 v224, v224, v228
  v_add_f32 v225, v225, v229
  v_add_f32 v226, v226, v230
  v_add_f32 v227, v227, v231
  v_mov_b32 v232, v224
  v_mov_b32 v233, s7
  v_mov_b32 v234, v225
  v_mov_b32 v235, s7
  v_mov_b32 v236, v226
  v_mov_b32 v237, s7
  v_mov_b32 v238, v227
  v_mov_b32 v239, s7
  s_mov_b64 s[14:15], exec
  s_mov_b64 exec, 0xf
  s_cmp_lg_u32 s42, 0
  s_cbranch_scc1 QST1
  global_store_dwordx4 v181, v[232:235], s[40:41]
  global_store_dwordx4 v181, v[236:239], s[40:41] offset:16
  global_store_dwordx4 v181, v[232:235], s[90:91] sc1
  global_store_dwordx4 v181, v[236:239], s[90:91] offset:16 sc1
  s_branch QST2
QST1:
  s_cmp_lg_u32 s13, 0
  s_cbranch_scc1 QST3
  global_store_dwordx4 v181, v[232:235], s[40:41] sc1
  global_store_dwordx4 v181, v[236:239], s[40:41] offset:16 sc1
  s_branch QST2
QST3:
  global_store_dwordx4 v181, v[232:235], s[40:41]
  global_store_dwordx4 v181, v[236:239], s[40:41] offset:16
QST2:
  s_mov_b64 exec, s[14:15]
  s_cmp_lg_u32 s42, 0
  s_cbranch_scc1 NOMW
  v_lshlrev_b32 v6, 1, v0
  ds_read_u16 v144, v6 offset:49152
  ds_read_u16 v152, v6 offset:52736
  ds_read_u16 v160, v6 offset:56320
  ds_read_u16 v145, v6 offset:49664
  ds_read_u16 v153, v6 offset:53248
  ds_read_u16 v161, v6 offset:56832
  ds_read_u16 v146, v6 offset:50176
  ds_read_u16 v154, v6 offset:53760
  ds_read_u16 v162, v6 offset:57344
  ds_read_u16 v147, v6 offset:50688
  ds_read_u16 v155, v6 offset:54272
  ds_read_u16 v163, v6 offset:57856
  ds_read_u16 v148, v6 offset:51200
  ds_read_u16 v156, v6 offset:54784
  ds_read_u16 v164, v6 offset:58368
  ds_read_u16 v149, v6 offset:51712
  ds_read_u16 v157, v6 offset:55296
  ds_read_u16 v165, v6 offset:58880
  ds_read_u16 v150, v6 offset:52224
  ds_read_u16 v158, v6 offset:55808
  ds_read_u16 v166, v6 offset:59392
  v_mov_b32 v151, 0
  v_mov_b32 v159, 0
  v_mov_b32 v167, 0
  v_mov_b32 v188, s48
  v_mov_b32 v189, s48
  s_waitcnt lgkmcnt(0)
  v_lshlrev_b32 v144, 16, v144
  v_lshlrev_b32 v152, 16, v152
  v_lshlrev_b32 v160, 16, v160
  v_lshlrev_b32 v145, 16, v145
  v_lshlrev_b32 v153, 16, v153
  v_lshlrev_b32 v161, 16, v161
  v_lshlrev_b32 v146, 16, v146
  v_lshlrev_b32 v154, 16, v154
  v_lshlrev_b32 v162, 16, v162
  v_lshlrev_b32 v147, 16, v147
  v_lshlrev_b32 v155, 16, v155
  v_lshlrev_b32 v163, 16, v163
  v_lshlrev_b32 v148, 16, v148
  v_lshlrev_b32 v156, 16, v156
  v_lshlrev_b32 v164, 16, v164
  v_lshlrev_b32 v149, 16, v149
  v_lshlrev_b32 v157, 16, v157
  v_lshlrev_b32 v165, 16, v165
  v_lshlrev_b32 v150, 16, v150
  v_lshlrev_b32 v158, 16, v158
  v_lshlrev_b32 v166, 16, v166
NOMW:
  v_add_u32 v225, 0x1000, v172
  v_add_u32 v226, 0x2000, v172
  v_add_u32 v227, 0x3000, v172
  s_mov_b32 s12, 0x100000
POLL1:
  s_and_b32 s8, s12, 7
  s_or_b32 s8, s8, s94
  s_cmp_eq_u32 s8, 1
  s_cselect_b64 s[92:93], s[90:91], s[40:41]
  global_load_dwordx4 v[192:195], v172, s[92:93] sc1
  global_load_dwordx4 v[196:199], v225, s[92:93] sc1
  global_load_dwordx4 v[200:203], v226, s[92:93] sc1
  global_load_dwordx4 v[204:207], v227, s[92:93] sc1
  s_waitcnt vmcnt(0)
  v_min3_u32 v208, v193, v195, v197
  v_max3_u32 v209, v193, v195, v197
  v_min3_u32 v208, v208, v199, v201
  v_max3_u32 v209, v209, v199, v201
  v_min3_u32 v208, v208, v203, v205
  v_max3_u32 v209, v209, v203, v205
  v_min_u32 v208, v208, v207
  v_max_u32 v209, v209, v207
  v_cmp_ne_u32 vcc, s7, v208
  v_cmp_ne_u32 s[8:9], s7, v209
  s_nop 0
  s_or_b64 vcc, vcc, s[8:9]
  s_cmp_eq_u64 vcc, 0
  s_cbranch_scc1 POLLX1
  s_sub_u32 s12, s12, 1
  s_cbranch_scc0 POLL1
POLLX1:
  v_add_f32 v192, v192, v196
  v_add_f32 v194, v194, v198
  v_add_f32 v200, v200, v204
  v_add_f32 v202, v202, v206
  v_add_f32 v192, v192, v200
  v_add_f32 v194, v194, v202
  v_cvt_pk_bf16_f32 v192, v192, v194
  v_lshlrev_b32 v6, 2, v0
  v_add_u32 v6, 0xec00, v6
  ds_write_b32 v6, v192
  s_waitcnt lgkmcnt(0)
SW:
  s_barrier
  ds_read_b128 v[192:195], v186 offset:0
  ds_read_b128 v[196:199], v186 offset:64
  ds_read_b128 v[200:203], v186 offset:128
  ds_read_b128 v[204:207], v186 offset:192
  s_waitcnt vmcnt(0) lgkmcnt(0)
  v_mfma_f32_16x16x32_bf16 v[224:227], v[48:51], v[192:195], 0
  v_mfma_f32_16x16x32_bf16 v[228:231], v[64:67], v[192:195], 0
  v_mfma_f32_16x16x32_bf16 v[224:227], v[52:55], v[196:199], v[224:227]
  v_mfma_f32_16x16x32_bf16 v[228:231], v[68:71], v[196:199], v[228:231]
  v_mfma_f32_16x16x32_bf16 v[224:227], v[56:59], v[200:203], v[224:227]
  v_mfma_f32_16x16x32_bf16 v[228:231], v[72:75], v[200:203], v[228:231]
  v_mfma_f32_16x16x32_bf16 v[224:227], v[60:63], v[204:207], v[224:227]
  v_mfma_f32_16x16x32_bf16 v[228:231], v[76:79], v[204:207], v[228:231]
  s_nop 7
  v_cvt_pk_bf16_f32 v232, v224, v225
  v_lshlrev_b32 v224, 16, v232
  v_and_b32 v225, 0xffff0000, v232
  v_pk_mul_f32 v[224:225], v[224:225], s[46:47] op_sel_hi:[1,0]
  v_cvt_pk_bf16_f32 v232, v224, v225
  v_lshlrev_b32 v224, 16, v232
  v_and_b32 v225, 0xffff0000, v232
  v_cvt_pk_bf16_f32 v232, v226, v227
  v_lshlrev_b32 v226, 16, v232
  v_and_b32 v227, 0xffff0000, v232
  v_pk_mul_f32 v[226:227], v[226:227], s[46:47] op_sel_hi:[1,0]
  v_cvt_pk_bf16_f32 v232, v226, v227
  v_lshlrev_b32 v226, 16, v232
  v_and_b32 v227, 0xffff0000, v232
  v_cvt_pk_bf16_f32 v232, v228, v229
  v_lshlrev_b32 v228, 16, v232
  v_and_b32 v229, 0xffff0000, v232
  v_pk_mul_f32 v[228:229], v[228:229], s[46:47] op_sel_hi:[1,0]
  v_cvt_pk_bf16_f32 v232, v228, v229
  v_lshlrev_b32 v228, 16, v232
  v_and_b32 v229, 0xffff0000, v232
  v_cvt_pk_bf16_f32 v232, v230, v231
  v_lshlrev_b32 v230, 16, v232
  v_and_b32 v231, 0xffff0000, v232
  v_pk_mul_f32 v[230:231], v[230:231], s[46:47] op_sel_hi:[1,0]
  v_cvt_pk_bf16_f32 v232, v230, v231
  v_lshlrev_b32 v230, 16, v232
  v_and_b32 v231, 0xffff0000, v232
  v_max3_f32 v233, v224, v225, v226
  v_max3_f32 v233, v233, v227, v228
  v_max3_f32 v233, v233, v229, v230
  v_max_f32 v233, v233, v231
  v_mov_b32 v232, v233
  s_nop 1
  v_permlane16_swap_b32 v233, v232
  v_max_f32 v233, v233, v232
  v_mov_b32 v232, v233
  s_nop 1
  v_permlane32_swap_b32 v233, v232
  v_max_f32 v233, v233, v232
  v_mul_f32 v234, s44, v233
  v_fma_f32 v224, v224, s44, -v234
  v_fma_f32 v225, v225, s44, -v234
  v_fma_f32 v226, v226, s44, -v234
  v_fma_f32 v227, v227, s44, -v234
  v_fma_f32 v228, v228, s44, -v234
  v_fma_f32 v229, v229, s44, -v234
  v_fma_f32 v230, v230, s44, -v234
  v_fma_f32 v231, v231, s44, -v234
  v_exp_f32 v224, v224
  v_exp_f32 v225, v225
  v_exp_f32 v226, v226
  v_exp_f32 v227, v227
  v_exp_f32 v228, v228
  v_exp_f32 v229, v229
  v_exp_f32 v230, v230
  v_exp_f32 v231, v231
  s_nop 0
  v_cvt_pk_bf16_f32 v236, v224, v225
  v_cvt_pk_bf16_f32 v237, v226, v227
  v_cvt_pk_bf16_f32 v238, v228, v229
  v_cvt_pk_bf16_f32 v239, v230, v231
  s_cmp_lg_u32 s42, 0
  s_cbranch_scc1 SV
  s_barrier
  v_xor_b32 v6, 0x0, v182
  ds_read_b64_tr_b16 v[80:81], v6
  ds_read_b64_tr_b16 v[82:83], v6 offset:4096
  v_xor_b32 v6, 0x20, v182
  ds_read_b64_tr_b16 v[84:85], v6
  ds_read_b64_tr_b16 v[86:87], v6 offset:4096
  v_xor_b32 v6, 0x40, v182
  ds_read_b64_tr_b16 v[88:89], v6
  ds_read_b64_tr_b16 v[90:91], v6 offset:4096
  v_xor_b32 v6, 0x60, v182
  ds_read_b64_tr_b16 v[92:93], v6
  ds_read_b64_tr_b16 v[94:95], v6 offset:4096
  v_xor_b32 v6, 0x80, v182
  ds_read_b64_tr_b16 v[96:97], v6
  ds_read_b64_tr_b16 v[98:99], v6 offset:4096
  v_xor_b32 v6, 0xa0, v182
  ds_read_b64_tr_b16 v[100:101], v6
  ds_read_b64_tr_b16 v[102:103], v6 offset:4096
  v_xor_b32 v6, 0xc0, v182
  ds_read_b64_tr_b16 v[104:105], v6
  ds_read_b64_tr_b16 v[106:107], v6 offset:4096
  v_xor_b32 v6, 0xe0, v182
  ds_read_b64_tr_b16 v[108:109], v6
  ds_read_b64_tr_b16 v[110:111], v6 offset:4096
  s_waitcnt lgkmcnt(0)
SV:
  v_mfma_f32_16x16x32_bf16 v[192:195], v[236:239], v[80:83], 0
  v_mfma_f32_16x16x32_bf16 v[196:199], v[236:239], v[84:87], 0
  v_mfma_f32_16x16x32_bf16 v[200:203], v[236:239], v[88:91], 0
  v_mfma_f32_16x16x32_bf16 v[204:207], v[236:239], v[92:95], 0
  v_mfma_f32_16x16x32_bf16 v[208:211], v[236:239], v[96:99], 0
  v_mfma_f32_16x16x32_bf16 v[212:215], v[236:239], v[100:103], 0
  v_mfma_f32_16x16x32_bf16 v[216:219], v[236:239], v[104:107], 0
  v_mfma_f32_16x16x32_bf16 v[220:223], v[236:239], v[108:111], 0
  v_pk_add_f32 v[224:225], v[224:225], v[226:227]
  v_pk_add_f32 v[228:229], v[228:229], v[230:231]
  v_pk_add_f32 v[224:225], v[224:225], v[228:229]
  v_add_f32 v235, v224, v225
  v_mov_b32 v232, v235
  s_nop 1
  v_permlane16_swap_b32 v235, v232
  v_add_f32 v235, v235, v232
  v_mov_b32 v232, v235
  s_nop 1
  v_permlane32_swap_b32 v235, v232
  v_add_f32 v235, v235, v232
  s_lshl_b32 s8, s4, 5
  s_add_u32 s8, s8, 0xea00
  v_lshlrev_b32 v6, 1, v1
  v_add_u32 v6, s8, v6
  v_mov_b32 v232, v233
  v_mov_b32 v233, v235
  s_mov_b64 s[14:15], exec
  s_mov_b64 exec, 0x1111
  ds_write_b64 v6, v[232:233]
  s_mov_b64 exec, s[14:15]
  ds_write_b32 v183, v192 offset:0
  ds_write_b32 v183, v196 offset:64
  ds_write_b32 v183, v200 offset:128
  ds_write_b32 v183, v204 offset:192
  ds_write_b32 v183, v208 offset:256
  ds_write_b32 v183, v212 offset:320
  ds_write_b32 v183, v216 offset:384
  ds_write_b32 v183, v220 offset:448
  s_waitcnt lgkmcnt(0)
  s_barrier
  ds_read_b64 v[192:193], v184 offset:0
  ds_read_b64 v[194:195], v184 offset:2048
  ds_read_b64 v[196:197], v184 offset:4096
  ds_read_b64 v[198:199], v184 offset:6144
  s_lshl_b32 s8, s4, 3
  s_add_u32 s8, s8, 0xea00
  v_mov_b32 v6, s8
  ds_read_b64 v[200:201], v6 offset:0
  ds_read_b64 v[202:203], v6 offset:32
  ds_read_b64 v[204:205], v6 offset:64
  ds_read_b64 v[206:207], v6 offset:96
  v_mov_b32 v7, 0xebc0
  ds_read_b32 v7, v7
  s_waitcnt lgkmcnt(0)
  v_readfirstlane_b32 s13, v7
  v_max3_f32 v208, v200, v202, v204
  v_max_f32 v208, v208, v206
  v_sub_f32 v209, v200, v208
  v_mul_f32 v209, s44, v209
  v_sub_f32 v210, v202, v208
  v_mul_f32 v210, s44, v210
  v_sub_f32 v211, v204, v208
  v_mul_f32 v211, s44, v211
  v_sub_f32 v212, v206, v208
  v_mul_f32 v212, s44, v212
  v_exp_f32 v209, v209
  v_exp_f32 v210, v210
  v_exp_f32 v211, v211
  v_exp_f32 v212, v212
  s_nop 0
  v_mul_f32 v214, v209, v201
  v_mul_f32 v216, v209, v192
  v_mul_f32 v218, v209, v193
  v_fmac_f32 v214, v210, v203
  v_fmac_f32 v216, v210, v194
  v_fmac_f32 v218, v210, v195
  v_fmac_f32 v214, v211, v205
  v_fmac_f32 v216, v211, v196
  v_fmac_f32 v218, v211, v197
  v_fmac_f32 v214, v212, v207
  v_fmac_f32 v216, v212, v198
  v_fmac_f32 v218, v212, v199
  v_mov_b32 v217, s7
  v_mov_b32 v219, s7
  s_cmp_lg_u32 s13, 0
  s_cbranch_scc1 GSF0
  global_store_dwordx4 v173, v[216:219], s[40:41] sc1
  s_branch GSD0
GSF0:
  global_store_dwordx4 v173, v[216:219], s[40:41]
GSD0:
  v_mov_b32 v220, v208
  v_mov_b32 v221, s7
  v_mov_b32 v222, v214
  v_mov_b32 v223, s7
  s_mov_b64 s[14:15], exec
  s_mov_b64 exec, 0x1
  s_cmp_lg_u32 s13, 0
  s_cbranch_scc1 GSF1
  global_store_dwordx4 v174, v[220:223], s[40:41] sc1
  s_branch GSD1
GSF1:
  global_store_dwordx4 v174, v[220:223], s[40:41]
GSD1:
  s_mov_b64 exec, s[14:15]
  s_cmp_lg_u32 s42, 0
  s_cbranch_scc1 OPH
  s_barrier
  s_lshl_b32 s8, s4, 12
  s_add_u32 s8, s8, 0x8000
  v_add_u32 v6, s8, v185
  ds_read_b128 v[224:227], v6 offset:0
  ds_read_b128 v[228:231], v6 offset:1024
  ds_read_b128 v[232:235], v6 offset:2048
  ds_read_b128 v[236:239], v6 offset:3072
  s_waitcnt lgkmcnt(0)
  v_lshlrev_b32 v112, 16, v224
  v_and_b32 v113, 0xffff0000, v224
  v_lshlrev_b32 v114, 16, v225
  v_and_b32 v115, 0xffff0000, v225
  v_lshlrev_b32 v116, 16, v226
  v_and_b32 v117, 0xffff0000, v226
  v_lshlrev_b32 v118, 16, v227
  v_and_b32 v119, 0xffff0000, v227
  v_lshlrev_b32 v120, 16, v228
  v_and_b32 v121, 0xffff0000, v228
  v_lshlrev_b32 v122, 16, v229
  v_and_b32 v123, 0xffff0000, v229
  v_lshlrev_b32 v124, 16, v230
  v_and_b32 v125, 0xffff0000, v230
  v_lshlrev_b32 v126, 16, v231
  v_and_b32 v127, 0xffff0000, v231
  v_lshlrev_b32 v128, 16, v232
  v_and_b32 v129, 0xffff0000, v232
  v_lshlrev_b32 v130, 16, v233
  v_and_b32 v131, 0xffff0000, v233
  v_lshlrev_b32 v132, 16, v234
  v_and_b32 v133, 0xffff0000, v234
  v_lshlrev_b32 v134, 16, v235
  v_and_b32 v135, 0xffff0000, v235
  v_lshlrev_b32 v136, 16, v236
  v_and_b32 v137, 0xffff0000, v236
  v_lshlrev_b32 v138, 16, v237
  v_and_b32 v139, 0xffff0000, v237
  v_lshlrev_b32 v140, 16, v238
  v_and_b32 v141, 0xffff0000, v238
  v_lshlrev_b32 v142, 16, v239
  v_and_b32 v143, 0xffff0000, v239
  v_lshlrev_b32 v168, 16, v168
  v_and_b32 v171, 0xffff0000, v170
  v_lshlrev_b32 v170, 16, v170
OPH:
  s_mov_b32 s12, 0x100000
POLL2:
  global_load_dwordx4 v[192:195], v175, s[40:41] sc1
  global_load_dwordx4 v[196:199], v176, s[40:41] sc1
  s_waitcnt vmcnt(0)
  v_min3_u32 v200, v193, v195, v197
  v_max3_u32 v201, v193, v195, v197
  v_min_u32 v200, v200, v199
  v_max_u32 v201, v201, v199
  v_cmp_ne_u32 vcc, s7, v200
  v_cmp_ne_u32 s[8:9], s7, v201
  s_nop 0
  s_or_b64 vcc, vcc, s[8:9]
  s_cmp_eq_u64 vcc, 0
  s_cbranch_scc1 POLLX2
  s_sub_u32 s12, s12, 1
  s_cbranch_scc0 POLL2
POLLX2:
  v_mov_b32 v200, v192
  s_nop 1
  v_max_f32_dpp v200, v200, v200 row_ror:2 row_mask:0xf bank_mask:0xf
  s_nop 1
  v_max_f32_dpp v200, v200, v200 row_ror:4 row_mask:0xf bank_mask:0xf
  s_nop 1
  v_max_f32_dpp v200, v200, v200 row_ror:8 row_mask:0xf bank_mask:0xf
  v_mov_b32 v201, v200
  s_nop 1
  v_permlane16_swap_b32 v200, v201
  v_max_f32 v200, v200, v201
  v_mov_b32 v201, v200
  s_nop 1
  v_permlane32_swap_b32 v200, v201
  v_max_f32 v200, v200, v201
  v_sub_f32 v202, v192, v200
  v_mul_f32 v202, s44, v202
  v_exp_f32 v202, v202
  s_nop 0
  v_mul_f32 v204, v202, v194
  v_mul_f32 v205, v202, v196
  v_mul_f32 v206, v202, v198
  s_nop 1
  v_add_f32_dpp v204, v204, v204 row_ror:2 row_mask:0xf bank_mask:0xf
  v_add_f32_dpp v205, v205, v205 row_ror:2 row_mask:0xf bank_mask:0xf
  v_add_f32_dpp v206, v206, v206 row_ror:2 row_mask:0xf bank_mask:0xf
  v_add_f32_dpp v204, v204, v204 row_ror:4 row_mask:0xf bank_mask:0xf
  v_add_f32_dpp v205, v205, v205 row_ror:4 row_mask:0xf bank_mask:0xf
  v_add_f32_dpp v206, v206, v206 row_ror:4 row_mask:0xf bank_mask:0xf
  v_add_f32_dpp v204, v204, v204 row_ror:8 row_mask:0xf bank_mask:0xf
  v_add_f32_dpp v205, v205, v205 row_ror:8 row_mask:0xf bank_mask:0xf
  v_add_f32_dpp v206, v206, v206 row_ror:8 row_mask:0xf bank_mask:0xf
  v_mov_b32 v208, v204
  v_mov_b32 v209, v205
  v_mov_b32 v210, v206
  v_permlane16_swap_b32 v204, v208
  v_permlane16_swap_b32 v205, v209
  v_permlane16_swap_b32 v206, v210
  v_add_f32 v204, v204, v208
  v_add_f32 v205, v205, v209
  v_add_f32 v206, v206, v210
  v_mov_b32 v208, v204
  v_mov_b32 v209, v205
  v_mov_b32 v210, v206
  v_permlane32_swap_b32 v204, v208
  v_permlane32_swap_b32 v205, v209
  v_permlane32_swap_b32 v206, v210
  v_add_f32 v204, v204, v208
  v_add_f32 v205, v205, v209
  v_add_f32 v206, v206, v210
  v_rcp_f32 v204, v204
  s_nop 0
  v_mul_f32 v205, v205, v204
  v_mul_f32 v206, v206, v204
  v_cvt_pk_bf16_f32 v208, v205, v206
  v_lshlrev_b32 v205, 16, v208
  v_and_b32 v206, 0xffff0000, v208
  s_nop 1
  v_mov_b32_dpp v212, v205 quad_perm:[0,0,2,2] row_mask:0xf bank_mask:0xf
  v_mov_b32_dpp v213, v206 quad_perm:[0,0,2,2] row_mask:0xf bank_mask:0xf
  v_mov_b32_dpp v214, v205 quad_perm:[1,1,3,3] row_mask:0xf bank_mask:0xf
  v_mov_b32_dpp v215, v206 quad_perm:[1,1,3,3] row_mask:0xf bank_mask:0xf
  v_pk_mul_f32 v[216:217], v[212:213], v[112:113] op_sel:[0,0] op_sel_hi:[0,1]
  v_pk_mul_f32 v[218:219], v[212:213], v[114:115] op_sel:[0,0] op_sel_hi:[0,1]
  v_pk_mul_f32 v[220:221], v[212:213], v[116:117] op_sel:[0,0] op_sel_hi:[0,1]
  v_pk_mul_f32 v[222:223], v[212:213], v[118:119] op_sel:[0,0] op_sel_hi:[0,1]
  v_pk_fma_f32 v[216:217], v[212:213], v[120:121], v[216:217] op_sel:[1,0,0] op_sel_hi:[1,1,1]
  v_pk_fma_f32 v[218:219], v[212:213], v[122:123], v[218:219] op_sel:[1,0,0] op_sel_hi:[1,1,1]
  v_pk_fma_f32 v[220:221], v[212:213], v[124:125], v[220:221] op_sel:[1,0,0] op_sel_hi:[1,1,1]
  v_pk_fma_f32 v[222:223], v[212:213], v[126:127], v[222:223] op_sel:[1,0,0] op_sel_hi:[1,1,1]
  v_pk_fma_f32 v[216:217], v[214:215], v[128:129], v[216:217] op_sel:[0,0,0] op_sel_hi:[0,1,1]
  v_pk_fma_f32 v[218:219], v[214:215], v[130:131], v[218:219] op_sel:[0,0,0] op_sel_hi:[0,1,1]
  v_pk_fma_f32 v[220:221], v[214:215], v[132:133], v[220:221] op_sel:[0,0,0] op_sel_hi:[0,1,1]
  v_pk_fma_f32 v[222:223], v[214:215], v[134:135], v[222:223] op_sel:[0,0,0] op_sel_hi:[0,1,1]
  v_pk_fma_f32 v[216:217], v[214:215], v[136:137], v[216:217] op_sel:[1,0,0] op_sel_hi:[1,1,1]
  v_pk_fma_f32 v[218:219], v[214:215], v[138:139], v[218:219] op_sel:[1,0,0] op_sel_hi:[1,1,1]
  v_pk_fma_f32 v[220:221], v[214:215], v[140:141], v[220:221] op_sel:[1,0,0] op_sel_hi:[1,1,1]
  v_pk_fma_f32 v[222:223], v[214:215], v[142:143], v[222:223] op_sel:[1,0,0] op_sel_hi:[1,1,1]
  s_lshl_b32 s8, s4, 11
  s_add_u32 s8, s8, 0x11800
  v_add_u32 v6, s8, v187
  ds_write_b128 v6, v[216:219]
  ds_write_b128 v6, v[220:223] offset:16
  v_lshlrev_b32 v6, 3, v0
  v_add_u32 v6, 0x11800, v6
  s_waitcnt lgkmcnt(0)
  s_barrier
  ds_read_b64 v[192:193], v6 offset:0
  ds_read_b64 v[194:195], v6 offset:2048
  ds_read_b64 v[196:197], v6 offset:4096
  ds_read_b64 v[198:199], v6 offset:6144
  s_waitcnt lgkmcnt(0)
  v_pk_add_f32 v[192:193], v[192:193], v[194:195]
  v_pk_add_f32 v[196:197], v[196:197], v[198:199]
  v_add_f32 v200, v192, v196
  v_add_f32 v202, v193, v197
  v_mov_b32 v201, s7
  v_mov_b32 v203, s7
  s_cmp_lg_u32 s13, 0
  s_cbranch_scc1 GSF2
  global_store_dwordx4 v177, v[200:203], s[40:41] sc1
  s_branch GSD2
GSF2:
  global_store_dwordx4 v177, v[200:203], s[40:41]
GSD2:
  s_cmp_lg_u32 s4, 0
  s_cbranch_scc1 MW
  v_add_u32 v233, 0x8000, v178
  v_add_u32 v234, 0x10000, v178
  v_add_u32 v235, 0x18000, v178
  ds_read_b64 v[236:237], v241
  s_mov_b32 s12, 0x100000
POLL3:
  global_load_dwordx4 v[208:211], v178, s[40:41] sc1
  global_load_dwordx4 v[212:215], v233, s[40:41] sc1
  global_load_dwordx4 v[216:219], v234, s[40:41] sc1
  global_load_dwordx4 v[220:223], v235, s[40:41] sc1
  s_waitcnt vmcnt(0)
  v_min3_u32 v224, v209, v211, v213
  v_max3_u32 v225, v209, v211, v213
  v_min3_u32 v224, v224, v215, v217
  v_max3_u32 v225, v225, v215, v217
  v_min3_u32 v224, v224, v219, v221
  v_max3_u32 v225, v225, v219, v221
  v_min_u32 v224, v224, v223
  v_max_u32 v225, v225, v223
  v_cmp_ne_u32 vcc, s7, v224
  v_cmp_ne_u32 s[8:9], s7, v225
  s_nop 0
  s_or_b64 vcc, vcc, s[8:9]
  s_cmp_eq_u64 vcc, 0
  s_cbranch_scc1 POLLX3
  s_sub_u32 s12, s12, 1
  s_cbranch_scc0 POLL3
POLLX3:
  v_add_f32 v224, v208, v212
  v_add_f32 v226, v210, v214
  v_add_f32 v216, v216, v220
  v_add_f32 v218, v218, v222
  v_add_f32 v224, v224, v216
  v_add_f32 v226, v226, v218
  s_nop 1
  v_add_f32_dpp v224, v224, v224 row_ror:8 row_mask:0xf bank_mask:0xf
  v_add_f32_dpp v226, v226, v226 row_ror:8 row_mask:0xf bank_mask:0xf
  v_mov_b32 v228, v224
  v_mov_b32 v229, v226
  s_nop 0
  v_permlane16_swap_b32 v224, v228
  v_permlane16_swap_b32 v226, v229
  v_add_f32 v224, v224, v228
  v_add_f32 v226, v226, v229
  v_mov_b32 v228, v224
  v_mov_b32 v229, v226
  s_nop 0
  v_permlane32_swap_b32 v224, v228
  v_permlane32_swap_b32 v226, v229
  v_add_f32 v224, v224, v228
  v_add_f32 v226, v226, v229
  v_mov_b32 v225, s7
  v_mov_b32 v227, s7
  global_store_dwordx4 v190, v[224:227], s[40:41] sc1
  s_mov_b32 s12, 0x100000
POLL4:
  global_load_dwordx4 v[208:211], v191, s[40:41] sc1
  s_waitcnt vmcnt(0)
  v_min_u32 v228, v209, v211
  v_max_u32 v229, v209, v211
  v_cmp_ne_u32 vcc, s7, v228
  v_cmp_ne_u32 s[8:9], s7, v229
  s_nop 0
  s_or_b64 vcc, vcc, s[8:9]
  s_cmp_eq_u64 vcc, 0
  s_cbranch_scc1 POLLX4
  s_sub_u32 s12, s12, 1
  s_cbranch_scc0 POLL4
POLLX4:
  v_mov_b32 v228, v208
  v_mov_b32 v229, v210
  s_nop 1
  v_add_f32_dpp v228, v228, v228 row_ror:8 row_mask:0xf bank_mask:0xf
  v_add_f32_dpp v229, v229, v229 row_ror:8 row_mask:0xf bank_mask:0xf
  v_mov_b32 v230, v228
  v_mov_b32 v231, v229
  s_nop 0
  v_permlane16_swap_b32 v228, v230
  v_permlane16_swap_b32 v229, v231
  v_add_f32 v228, v228, v230
  v_add_f32 v229, v229, v231
  v_mov_b32 v230, v228
  v_mov_b32 v231, v229
  s_nop 0
  v_permlane32_swap_b32 v228, v230
  v_permlane32_swap_b32 v229, v231
  v_add_f32 v228, v228, v230
  v_add_f32 v229, v229, v231
  v_cvt_pk_bf16_f32 v230, v228, v229
  v_lshlrev_b32 v228, 16, v230
  v_and_b32 v229, 0xffff0000, v230
  s_waitcnt lgkmcnt(0)
  v_pk_add_f32 v[228:229], v[228:229], v[236:237]
  v_cvt_pk_bf16_f32 v232, v228, v229
  v_mov_b32 v233, s7
  s_mov_b64 s[14:15], exec
  s_mov_b64 exec, 0xff
  s_cmp_lg_u32 s13, 0
  s_cbranch_scc1 X1F
  global_store_dwordx2 v240, v[232:233], s[40:41] sc1
  s_branch X1D
X1F:
  global_store_dwordx2 v240, v[232:233], s[40:41]
X1D:
  s_mov_b64 exec, s[14:15]
  v_readlane_b32 s10, v232, s5
  s_nop 1
  s_lshl_b32 s11, s10, 16
  s_and_b32 s10, s10, 0xffff0000
  v_mov_b32 v170, s11
  v_mov_b32 v171, s10
  s_mov_b32 s12, 0x100000
POLL5:
  global_load_dwordx4 v[200:203], v179, s[40:41] sc1
  global_load_dwordx4 v[204:207], v179, s[40:41] offset:16 sc1
  s_waitcnt vmcnt(0)
  v_min3_u32 v210, v201, v203, v205
  v_max3_u32 v211, v201, v203, v205
  v_min_u32 v210, v210, v207
  v_max_u32 v211, v211, v207
  v_cmp_ne_u32 vcc, s7, v210
  v_cmp_ne_u32 s[8:9], s7, v211
  s_nop 0
  s_or_b64 vcc, vcc, s[8:9]
  s_cmp_eq_u64 vcc, 0
  s_cbranch_scc1 POLLX5
  s_sub_u32 s12, s12, 1
  s_cbranch_scc0 POLL5
POLLX5:
  v_lshlrev_b32 v192, 16, v200
  v_and_b32 v193, 0xffff0000, v200
  v_lshlrev_b32 v194, 16, v202
  v_and_b32 v195, 0xffff0000, v202
  v_lshlrev_b32 v196, 16, v204
  v_and_b32 v197, 0xffff0000, v204
  v_lshlrev_b32 v198, 16, v206
  v_and_b32 v199, 0xffff0000, v206
  v_mov_b32 v210, v170
  v_mov_b32 v211, v171
  s_nop 0
  v_readfirstlane_b32 s52, v192
  s_nop 0
  s_xor_b32 s54, s52, 0x80000000
  s_nop 0
  v_pk_add_f32 v[216:217], v[192:193], s[54:55] op_sel_hi:[1,0]
  v_pk_mul_f32 v[218:219], v[216:217], v[216:217]
  v_pk_add_f32 v[220:221], v[194:195], s[54:55] op_sel_hi:[1,0]
  v_pk_add_f32 v[216:217], v[216:217], v[220:221]
  v_pk_fma_f32 v[218:219], v[220:221], v[220:221], v[218:219]
  v_pk_add_f32 v[220:221], v[196:197], s[54:55] op_sel_hi:[1,0]
  v_pk_add_f32 v[216:217], v[216:217], v[220:221]
  v_pk_fma_f32 v[218:219], v[220:221], v[220:221], v[218:219]
  v_pk_add_f32 v[220:221], v[198:199], s[54:55] op_sel_hi:[1,0]
  v_pk_add_f32 v[216:217], v[216:217], v[220:221]
  v_pk_fma_f32 v[218:219], v[220:221], v[220:221], v[218:219]
  v_add_f32 v216, v216, v217
  v_add_f32 v218, v218, v219
  s_nop 1
  v_add_f32_dpp v216, v216, v216 row_ror:1 row_mask:0xf bank_mask:0xf
  v_add_f32_dpp v218, v218, v218 row_ror:1 row_mask:0xf bank_mask:0xf
  s_nop 0
  v_add_f32_dpp v216, v216, v216 row_ror:2 row_mask:0xf bank_mask:0xf
  v_add_f32_dpp v218, v218, v218 row_ror:2 row_mask:0xf bank_mask:0xf
  s_nop 0
  v_add_f32_dpp v216, v216, v216 row_ror:4 row_mask:0xf bank_mask:0xf
  v_add_f32_dpp v218, v218, v218 row_ror:4 row_mask:0xf bank_mask:0xf
  s_nop 0
  v_add_f32_dpp v216, v216, v216 row_ror:8 row_mask:0xf bank_mask:0xf
  v_add_f32_dpp v218, v218, v218 row_ror:8 row_mask:0xf bank_mask:0xf
  v_mov_b32 v223, v216
  v_mov_b32 v225, v218
  s_nop 0
  v_permlane16_swap_b32 v216, v223
  v_permlane16_swap_b32 v218, v225
  v_add_f32 v216, v216, v223
  v_add_f32 v218, v218, v225
  v_mov_b32 v223, v216
  v_mov_b32 v225, v218
  s_nop 0
  v_permlane32_swap_b32 v216, v223
  v_permlane32_swap_b32 v218, v225
  v_add_f32 v216, v216, v223
  v_add_f32 v218, v218, v225
  v_mul_f32 v216, 0x3b000000, v216
  v_mul_f32 v218, 0x3b000000, v218
  v_fma_f32 v218, -v216, v216, v218
  v_max_f32 v218, 0, v218
  v_add_f32 v222, s52, v216
  v_cvt_pk_bf16_f32 v223, v222, v218
  v_lshlrev_b32 v222, 16, v223
  v_and_b32 v218, 0xffff0000, v223
  v_add_f32 v218, 0x3727c5ac, v218
  v_cvt_pk_bf16_f32 v223, v218, v218
  v_lshlrev_b32 v218, 16, v223
  v_sqrt_f32 v218, v218
  v_xor_b32 v222, 0x80000000, v222
  v_cvt_pk_bf16_f32 v223, v218, v218
  v_lshlrev_b32 v218, 16, v223
  v_rcp_f32 v224, v218
  v_pk_add_f32 v[192:193], v[192:193], v[222:223] op_sel_hi:[1,0]
  v_cvt_pk_bf16_f32 v223, v192, v193
  v_lshlrev_b32 v192, 16, v223
  v_and_b32 v193, 0xffff0000, v223
  v_pk_mul_f32 v[192:193], v[192:193], v[224:225] op_sel_hi:[1,0]
  v_cvt_pk_bf16_f32 v223, v192, v193
  v_lshlrev_b32 v192, 16, v223
  v_and_b32 v193, 0xffff0000, v223
  v_pk_add_f32 v[194:195], v[194:195], v[222:223] op_sel_hi:[1,0]
  v_cvt_pk_bf16_f32 v223, v194, v195
  v_lshlrev_b32 v194, 16, v223
  v_and_b32 v195, 0xffff0000, v223
  v_pk_mul_f32 v[194:195], v[194:195], v[224:225] op_sel_hi:[1,0]
  v_cvt_pk_bf16_f32 v223, v194, v195
  v_lshlrev_b32 v194, 16, v223
  v_and_b32 v195, 0xffff0000, v223
  v_pk_add_f32 v[196:197], v[196:197], v[222:223] op_sel_hi:[1,0]
  v_cvt_pk_bf16_f32 v223, v196, v197
  v_lshlrev_b32 v196, 16, v223
  v_and_b32 v197, 0xffff0000, v223
  v_pk_mul_f32 v[196:197], v[196:197], v[224:225] op_sel_hi:[1,0]
  v_cvt_pk_bf16_f32 v223, v196, v197
  v_lshlrev_b32 v196, 16, v223
  v_and_b32 v197, 0xffff0000, v223
  v_pk_add_f32 v[198:199], v[198:199], v[222:223] op_sel_hi:[1,0]
  v_cvt_pk_bf16_f32 v223, v198, v199
  v_lshlrev_b32 v198, 16, v223
  v_and_b32 v199, 0xffff0000, v223
  v_pk_mul_f32 v[198:199], v[198:199], v[224:225] op_sel_hi:[1,0]
  v_cvt_pk_bf16_f32 v223, v198, v199
  v_lshlrev_b32 v198, 16, v223
  v_and_b32 v199, 0xffff0000, v223
  v_pk_add_f32 v[210:211], v[210:211], v[222:223] op_sel_hi:[1,0]
  v_cvt_pk_bf16_f32 v223, v210, v211
  v_lshlrev_b32 v210, 16, v223
  v_and_b32 v211, 0xffff0000, v223
  v_pk_mul_f32 v[210:211], v[210:211], v[224:225] op_sel_hi:[1,0]
  v_cvt_pk_bf16_f32 v223, v210, v211
  v_lshlrev_b32 v210, 16, v223
  v_and_b32 v211, 0xffff0000, v223
  s_nop 0
  v_readfirstlane_b32 s52, v192
  s_nop 0
  s_xor_b32 s54, s52, 0x80000000
  s_nop 0
  v_pk_add_f32 v[216:217], v[192:193], s[54:55] op_sel_hi:[1,0]
  v_pk_mul_f32 v[218:219], v[216:217], v[216:217]
  v_pk_add_f32 v[220:221], v[194:195], s[54:55] op_sel_hi:[1,0]
  v_pk_add_f32 v[216:217], v[216:217], v[220:221]
  v_pk_fma_f32 v[218:219], v[220:221], v[220:221], v[218:219]
  v_pk_add_f32 v[220:221], v[196:197], s[54:55] op_sel_hi:[1,0]
  v_pk_add_f32 v[216:217], v[216:217], v[220:221]
  v_pk_fma_f32 v[218:219], v[220:221], v[220:221], v[218:219]
  v_pk_add_f32 v[220:221], v[198:199], s[54:55] op_sel_hi:[1,0]
  v_pk_add_f32 v[216:217], v[216:217], v[220:221]
  v_pk_fma_f32 v[218:219], v[220:221], v[220:221], v[218:219]
  v_add_f32 v216, v216, v217
  v_add_f32 v218, v218, v219
  s_nop 1
  v_add_f32_dpp v216, v216, v216 row_ror:1 row_mask:0xf bank_mask:0xf
  v_add_f32_dpp v218, v218, v218 row_ror:1 row_mask:0xf bank_mask:0xf
  s_nop 0
  v_add_f32_dpp v216, v216, v216 row_ror:2 row_mask:0xf bank_mask:0xf
  v_add_f32_dpp v218, v218, v218 row_ror:2 row_mask:0xf bank_mask:0xf
  s_nop 0
  v_add_f32_dpp v216, v216, v216 row_ror:4 row_mask:0xf bank_mask:0xf
  v_add_f32_dpp v218, v218, v218 row_ror:4 row_mask:0xf bank_mask:0xf
  s_nop 0
  v_add_f32_dpp v216, v216, v216 row_ror:8 row_mask:0xf bank_mask:0xf
  v_add_f32_dpp v218, v218, v218 row_ror:8 row_mask:0xf bank_mask:0xf
  v_mov_b32 v223, v216
  v_mov_b32 v225, v218
  s_nop 0
  v_permlane16_swap_b32 v216, v223
  v_permlane16_swap_b32 v218, v225
  v_add_f32 v216, v216, v223
  v_add_f32 v218, v218, v225
  v_mov_b32 v223, v216
  v_mov_b32 v225, v218
  s_nop 0
  v_permlane32_swap_b32 v216, v223
  v_permlane32_swap_b32 v218, v225
  v_add_f32 v216, v216, v223
  v_add_f32 v218, v218, v225
  v_mul_f32 v216, 0x3b000000, v216
  v_mul_f32 v218, 0x3b000000, v218
  v_fma_f32 v218, -v216, v216, v218
  v_max_f32 v218, 0, v218
  v_add_f32 v222, s52, v216
  v_cvt_pk_bf16_f32 v223, v222, v218
  v_lshlrev_b32 v222, 16, v223
  v_and_b32 v218, 0xffff0000, v223
  v_add_f32 v218, 0x3727c5ac, v218
  v_cvt_pk_bf16_f32 v223, v218, v218
  v_lshlrev_b32 v218, 16, v223
  v_sqrt_f32 v218, v218
  v_xor_b32 v222, 0x80000000, v222
  v_cvt_pk_bf16_f32 v223, v218, v218
  v_lshlrev_b32 v218, 16, v223
  v_rcp_f32 v224, v218
  v_pk_add_f32 v[210:211], v[210:211], v[222:223] op_sel_hi:[1,0]
  v_cvt_pk_bf16_f32 v223, v210, v211
  v_lshlrev_b32 v210, 16, v223
  v_and_b32 v211, 0xffff0000, v223
  v_pk_mul_f32 v[210:211], v[210:211], v[224:225] op_sel_hi:[1,0]
  v_cvt_pk_bf16_f32 v223, v210, v211
  v_lshlrev_b32 v210, 16, v223
  v_and_b32 v211, 0xffff0000, v223
  v_mov_b32 v6, 0xeb80
  s_mov_b64 s[14:15], exec
  s_mov_b64 exec, 0x1
  ds_write_b64 v6, v[210:211]
  s_mov_b64 exec, s[14:15]
  s_waitcnt lgkmcnt(0)
  s_barrier
  s_branch MG
MW:
  v_mov_b32 v6, 0xeb80
  s_barrier
  ds_read_b64 v[210:211], v6
  s_waitcnt lgkmcnt(0)
MG:
  v_pk_mul_f32 v[216:217], v[144:145], v[210:211] op_sel:[0,0] op_sel_hi:[1,0]
  v_cvt_pk_bf16_f32 v220, v216, v217
  v_lshlrev_b32 v216, 16, v220
  v_and_b32 v217, 0xffff0000, v220
  v_pk_add_f32 v[216:217], v[216:217], v[152:153]
  v_cvt_pk_bf16_f32 v220, v216, v217
  v_lshlrev_b32 v216, 16, v220
  v_and_b32 v217, 0xffff0000, v220
  v_pk_mul_f32 v[218:219], v[216:217], v[216:217]
  v_pk_fma_f32 v[218:219], v[218:219], s[50:51], v[188:189] op_sel_hi:[1,0,1]
  v_pk_mul_f32 v[218:219], v[218:219], v[216:217]
  v_exp_f32 v218, v218
  v_exp_f32 v219, v219
  s_nop 0
  v_pk_add_f32 v[218:219], v[218:219], 1.0 op_sel_hi:[1,0]
  v_rcp_f32 v218, v218
  v_rcp_f32 v219, v219
  s_nop 0
  v_pk_mul_f32 v[216:217], v[216:217], v[218:219]
  v_cvt_pk_bf16_f32 v220, v216, v217
  v_lshlrev_b32 v216, 16, v220
  v_and_b32 v217, 0xffff0000, v220
  v_pk_mul_f32 v[214:215], v[216:217], v[160:161]
  v_pk_mul_f32 v[216:217], v[146:147], v[210:211] op_sel:[0,0] op_sel_hi:[1,0]
  v_cvt_pk_bf16_f32 v220, v216, v217
  v_lshlrev_b32 v216, 16, v220
  v_and_b32 v217, 0xffff0000, v220
  v_pk_add_f32 v[216:217], v[216:217], v[154:155]
  v_cvt_pk_bf16_f32 v220, v216, v217
  v_lshlrev_b32 v216, 16, v220
  v_and_b32 v217, 0xffff0000, v220
  v_pk_mul_f32 v[218:219], v[216:217], v[216:217]
  v_pk_fma_f32 v[218:219], v[218:219], s[50:51], v[188:189] op_sel_hi:[1,0,1]
  v_pk_mul_f32 v[218:219], v[218:219], v[216:217]
  v_exp_f32 v218, v218
  v_exp_f32 v219, v219
  s_nop 0
  v_pk_add_f32 v[218:219], v[218:219], 1.0 op_sel_hi:[1,0]
  v_rcp_f32 v218, v218
  v_rcp_f32 v219, v219
  s_nop 0
  v_pk_mul_f32 v[216:217], v[216:217], v[218:219]
  v_cvt_pk_bf16_f32 v220, v216, v217
  v_lshlrev_b32 v216, 16, v220
  v_and_b32 v217, 0xffff0000, v220
  v_pk_fma_f32 v[214:215], v[216:217], v[162:163], v[214:215]
  v_pk_mul_f32 v[216:217], v[148:149], v[210:211] op_sel:[0,0] op_sel_hi:[1,0]
  v_cvt_pk_bf16_f32 v220, v216, v217
  v_lshlrev_b32 v216, 16, v220
  v_and_b32 v217, 0xffff0000, v220
  v_pk_add_f32 v[216:217], v[216:217], v[156:157]
  v_cvt_pk_bf16_f32 v220, v216, v217
  v_lshlrev_b32 v216, 16, v220
  v_and_b32 v217, 0xffff0000, v220
  v_pk_mul_f32 v[218:219], v[216:217], v[216:217]
  v_pk_fma_f32 v[218:219], v[218:219], s[50:51], v[188:189] op_sel_hi:[1,0,1]
  v_pk_mul_f32 v[218:219], v[218:219], v[216:217]
  v_exp_f32 v218, v218
  v_exp_f32 v219, v219
  s_nop 0
  v_pk_add_f32 v[218:219], v[218:219], 1.0 op_sel_hi:[1,0]
  v_rcp_f32 v218, v218
  v_rcp_f32 v219, v219
  s_nop 0
  v_pk_mul_f32 v[216:217], v[216:217], v[218:219]
  v_cvt_pk_bf16_f32 v220, v216, v217
  v_lshlrev_b32 v216, 16, v220
  v_and_b32 v217, 0xffff0000, v220
  v_pk_fma_f32 v[214:215], v[216:217], v[164:165], v[214:215]
  v_pk_mul_f32 v[216:217], v[150:151], v[210:211] op_sel:[0,0] op_sel_hi:[1,0]
  v_cvt_pk_bf16_f32 v220, v216, v217
  v_lshlrev_b32 v216, 16, v220
  v_and_b32 v217, 0xffff0000, v220
  v_pk_add_f32 v[216:217], v[216:217], v[158:159]
  v_cvt_pk_bf16_f32 v220, v216, v217
  v_lshlrev_b32 v216, 16, v220
  v_and_b32 v217, 0xffff0000, v220
  v_pk_mul_f32 v[218:219], v[216:217], v[216:217]
  v_pk_fma_f32 v[218:219], v[218:219], s[50:51], v[188:189] op_sel_hi:[1,0,1]
  v_pk_mul_f32 v[218:219], v[218:219], v[216:217]
  v_exp_f32 v218, v218
  v_exp_f32 v219, v219
  s_nop 0
  v_pk_add_f32 v[218:219], v[218:219], 1.0 op_sel_hi:[1,0]
  v_rcp_f32 v218, v218
  v_rcp_f32 v219, v219
  s_nop 0
  v_pk_mul_f32 v[216:217], v[216:217], v[218:219]
  v_cvt_pk_bf16_f32 v220, v216, v217
  v_lshlrev_b32 v216, 16, v220
  v_and_b32 v217, 0xffff0000, v220
  v_pk_fma_f32 v[214:215], v[216:217], v[166:167], v[214:215]
  v_add_f32 v214, v214, v215
  s_nop 1
  v_add_f32_dpp v214, v214, v214 row_ror:1 row_mask:0xf bank_mask:0xf
  s_nop 1
  v_add_f32_dpp v214, v214, v214 row_ror:2 row_mask:0xf bank_mask:0xf
  s_nop 1
  v_add_f32_dpp v214, v214, v214 row_ror:4 row_mask:0xf bank_mask:0xf
  s_nop 1
  v_add_f32_dpp v214, v214, v214 row_ror:8 row_mask:0xf bank_mask:0xf
  v_mov_b32 v216, v214
  s_nop 1
  v_permlane16_swap_b32 v214, v216
  v_add_f32 v214, v214, v216
  v_mov_b32 v216, v214
  s_nop 1
  v_permlane32_swap_b32 v214, v216
  v_add_f32 v214, v214, v216
  s_lshl_b32 s8, s4, 2
  s_add_u32 s8, s8, 0xeb00
  v_mov_b32 v6, s8
  s_mov_b64 s[14:15], exec
  s_mov_b64 exec, 0x1
  ds_write_b32 v6, v214
  s_mov_b64 exec, s[14:15]
  s_waitcnt lgkmcnt(0)
  s_barrier
  s_cmp_lg_u32 s4, 0
  s_cbranch_scc1 MSKIP
  v_mov_b32 v6, 0xeb00
  ds_read_b128 v[216:219], v6
  ds_read_b128 v[220:223], v6 offset:16
  s_waitcnt lgkmcnt(0)
  v_pk_add_f32 v[216:217], v[216:217], v[218:219]
  v_pk_add_f32 v[220:221], v[220:221], v[222:223]
  v_add_f32 v214, v216, v217
  v_add_f32 v215, v220, v221
  v_cvt_pk_bf16_f32 v216, v214, v215
  v_lshlrev_b32 v214, 16, v216
  v_and_b32 v215, 0xffff0000, v216
  v_add_f32 v214, v214, v168
  v_add_f32 v215, v215, v168
  v_cvt_pk_bf16_f32 v216, v214, v215
  v_lshlrev_b32 v214, 16, v216
  v_and_b32 v215, 0xffff0000, v216
  v_pk_add_f32 v[214:215], v[214:215], v[170:171]
  v_cvt_pk_bf16_f32 v218, v214, v215
  v_mov_b32 v219, s7
  s_cmp_lg_u32 s42, 0
  s_cbranch_scc1 FINAL
  v_add_u32 v6, 0x10000, v180
  s_mov_b64 s[14:15], exec
  s_mov_b64 exec, 0xff
  global_store_dwordx2 v6, v[218:219], s[40:41] sc1
  s_mov_b64 exec, s[14:15]
  v_lshlrev_b32 v170, 16, v218
  v_and_b32 v171, 0xffff0000, v218
  s_branch MDONE
FINAL:
  s_lshl_b32 s8, s43, 2
  v_mov_b32 v6, s8
  s_mov_b64 s[14:15], exec
  s_mov_b64 exec, 0x1
  global_store_dword v6, v218, s[36:37]
  s_cmp_lg_u32 s2, 0
  s_cbranch_scc1 NOEP
  v_mov_b32 v6, 0
  global_store_dword v6, v219, s[40:41]
NOEP:
  s_mov_b64 exec, s[14:15]
MDONE:
MSKIP:
  s_add_u32 s7, s7, 1
  s_add_u32 s42, s42, 1
  s_cmp_lt_u32 s42, 2
  s_cbranch_scc1 LAYER
  s_branch END
LOADER:
  s_sub_u32 s4, s4, 4
  s_load_dword s7, s[40:41], 0
  s_getreg_b32 s52, hwreg(HW_REG_XCC_ID)
  s_cmp_lg_u32 s4, 3
  s_cbranch_scc1 NOID
  s_lshl_b32 s8, s5, 8
  s_lshl_b32 s9, s6, 3
  s_add_u32 s8, s8, s9
  s_add_u32 s8, s8, 0xc000
  v_mov_b32 v6, s8
  v_mov_b32 v192, s52
  s_waitcnt lgkmcnt(0)
  s_add_u32 s8, s7, 1
  v_mov_b32 v193, s8
  s_mov_b64 s[14:15], exec
  s_mov_b64 exec, 0x1
  global_store_dwordx2 v6, v[192:193], s[40:41] sc1
  s_mov_b64 exec, s[14:15]
NOID:
  s_lshl_b32 s9, s4, 10
  v_add_u32 v6, s9, v185
  s_mov_b64 s[14:15], exec
  s_cmp_lg_u32 s4, 3
  s_cbranch_scc1 LD_FULL
  s_mov_b32 exec_hi, 0
LD_FULL:
  s_add_u32 s11, s9, 0xc000
  s_mov_b32 m0, s11
  s_nop 0
  global_load_lds_dwordx4 v6, s[28:29]
  s_add_u32 s11, s9, 0xce00
  s_mov_b32 m0, s11
  s_nop 0
  global_load_lds_dwordx4 v6, s[30:31]
  s_add_u32 s11, s9, 0xdc00
  s_mov_b32 m0, s11
  s_nop 0
  global_load_lds_dwordx4 v6, s[32:33]
  s_mov_b64 exec, s[14:15]
  v_lshrrev_b32 v3, 3, v1
  v_lshlrev_b32 v3, 13, v3
  v_and_b32 v4, 7, v1
  v_lshl_add_u32 v3, v4, 4, v3
  s_lshl_b32 s8, s88, 20
  s_lshl_b32 s9, s4, 18
  s_add_u32 s8, s8, s9
  s_lshl_b32 s9, s5, 10
  s_add_u32 s8, s8, s9
  s_lshl_b32 s9, s95, 7
  s_add_u32 s8, s8, s9
  v_add_u32 v3, s8, v3
  s_lshl_b32 s10, s4, 12
  s_add_u32 s11, s10, 0x13800
  s_mov_b32 m0, s11
  s_nop 0
  global_load_lds_dwordx4 v3, s[22:23] nt
  v_add_u32 v3, 0x10000, v3
  s_add_u32 s11, s10, 0x13c00
  s_mov_b32 m0, s11
  s_nop 0
  global_load_lds_dwordx4 v3, s[22:23] nt
  v_add_u32 v3, 0x10000, v3
  s_add_u32 s11, s10, 0x14000
  s_mov_b32 m0, s11
  s_nop 0
  global_load_lds_dwordx4 v3, s[22:23] nt
  v_add_u32 v3, 0x10000, v3
  s_add_u32 s11, s10, 0x14400
  s_mov_b32 m0, s11
  s_nop 0
  global_load_lds_dwordx4 v3, s[22:23] nt
  v_add_u32 v3, 0x10000, v3
  v_and_b32 v3, 15, v1
  v_lshrrev_b32 v4, 4, v1
  v_lshrrev_b32 v5, 1, v3
  v_xor_b32 v6, v5, v4
  v_xor_b32 v7, 4, v6
  v_and_b32 v5, 1, v3
  v_lshl_add_u32 v6, v6, 1, v5
  v_lshl_add_u32 v7, v7, 1, v5
  v_lshlrev_b32 v6, 4, v6
  v_lshlrev_b32 v7, 4, v7
  v_lshl_add_u32 v6, v4, 8, v6
  v_lshl_add_u32 v7, v4, 8, v7
  s_lshl_b32 s8, s5, 24
  s_lshl_b32 s9, s6, 15
  s_add_u32 s8, s8, s9
  s_lshl_b32 s9, s4, 13
  s_add_u32 s8, s8, s9
  s_add_u32 s8, s8, 0xf00000
  v_add_u32 v6, s8, v6
  v_add_u32 v7, s8, v7
  v_add_u32 v7, 0x400, v7
  s_lshl_b32 s10, s4, 13
  s_waitcnt vmcnt(4)
  s_add_u32 s11, s10, 0x0
  s_mov_b32 m0, s11
  s_nop 0
  global_load_lds_dwordx4 v6, s[20:21] nt
  v_add_u32 v6, 0x800, v6
  s_add_u32 s11, s10, 0x400
  s_mov_b32 m0, s11
  s_nop 0
  global_load_lds_dwordx4 v7, s[20:21] nt
  v_add_u32 v7, 0x800, v7
  s_add_u32 s11, s10, 0x800
  s_mov_b32 m0, s11
  s_nop 0
  global_load_lds_dwordx4 v6, s[20:21] nt
  v_add_u32 v6, 0x800, v6
  s_add_u32 s11, s10, 0xc00
  s_mov_b32 m0, s11
  s_nop 0
  global_load_lds_dwordx4 v7, s[20:21] nt
  v_add_u32 v7, 0x800, v7
  s_add_u32 s11, s10, 0x1000
  s_mov_b32 m0, s11
  s_nop 0
  global_load_lds_dwordx4 v6, s[20:21] nt
  v_add_u32 v6, 0x800, v6
  s_add_u32 s11, s10, 0x1400
  s_mov_b32 m0, s11
  s_nop 0
  global_load_lds_dwordx4 v7, s[20:21] nt
  v_add_u32 v7, 0x800, v7
  s_add_u32 s11, s10, 0x1800
  s_mov_b32 m0, s11
  s_nop 0
  global_load_lds_dwordx4 v6, s[20:21] nt
  v_add_u32 v6, 0x800, v6
  s_add_u32 s11, s10, 0x1c00
  s_mov_b32 m0, s11
  s_nop 0
  global_load_lds_dwordx4 v7, s[20:21] nt
  v_add_u32 v7, 0x800, v7
  s_lshl_b32 s8, s5, 8
  s_add_u32 s8, s8, 0xc000
  v_and_b32 v9, 31, v1
  v_lshlrev_b32 v9, 3, v9
  v_add_u32 v9, s8, v9
  global_load_dwordx2 v[196:197], v9, s[40:41] sc1
  s_waitcnt vmcnt(9) lgkmcnt(0)
  s_add_u32 s7, s7, 1
  s_barrier
  s_barrier
  s_waitcnt vmcnt(0)
  s_lshl_b32 s8, s5, 19
  s_lshl_b32 s9, s6, 14
  s_add_u32 s8, s8, s9
  s_lshl_b32 s9, s4, 12
  s_add_u32 s8, s8, s9
  v_add_u32 v6, s8, v185
  s_lshl_b32 s9, s4, 12
  s_add_u32 s11, s9, 0x8000
  s_mov_b32 m0, s11
  s_nop 0
  global_load_lds_dwordx4 v6, s[24:25] nt
  v_add_u32 v6, 0x400, v6
  s_add_u32 s11, s9, 0x8400
  s_mov_b32 m0, s11
  s_nop 0
  global_load_lds_dwordx4 v6, s[24:25] nt
  v_add_u32 v6, 0x400, v6
  s_add_u32 s11, s9, 0x8800
  s_mov_b32 m0, s11
  s_nop 0
  global_load_lds_dwordx4 v6, s[24:25] nt
  v_add_u32 v6, 0x400, v6
  s_add_u32 s11, s9, 0x8c00
  s_mov_b32 m0, s11
  s_nop 0
  global_load_lds_dwordx4 v6, s[24:25] nt
  v_add_u32 v6, 0x400, v6
  s_cmp_lg_u32 s4, 3
  s_cbranch_scc1 NOID2
  s_mov_b32 s12, 0x100000
IDP:
  v_cmp_ne_u32 vcc, s7, v197
  s_nop 0
  s_cmp_eq_u64 vcc, 0
  s_cbranch_scc1 IDD
  global_load_dwordx2 v[196:197], v9, s[40:41] sc1
  s_waitcnt vmcnt(0)
  s_sub_u32 s12, s12, 1
  s_cbranch_scc0 IDP
IDD:
  v_cmp_ne_u32 vcc, s52, v196
  s_nop 0
  s_cmp_eq_u64 vcc, 0
  s_cselect_b32 s11, 1, 0
  v_mov_b32 v7, s11
  v_mov_b32 v6, 0xebc0
  ds_write_b32 v6, v7
  s_waitcnt lgkmcnt(0)
NOID2:
  s_barrier
  s_barrier
  s_waitcnt vmcnt(0)
  s_barrier
  v_and_b32 v8, 255, v0
  v_lshlrev_b32 v6, 1, v8
  ds_read_u16 v144, v6 offset:49152
  ds_read_u16 v152, v6 offset:52736
  ds_read_u16 v160, v6 offset:56320
  ds_read_u16 v145, v6 offset:49664
  ds_read_u16 v153, v6 offset:53248
  ds_read_u16 v161, v6 offset:56832
  ds_read_u16 v146, v6 offset:50176
  ds_read_u16 v154, v6 offset:53760
  ds_read_u16 v162, v6 offset:57344
  ds_read_u16 v147, v6 offset:50688
  ds_read_u16 v155, v6 offset:54272
  ds_read_u16 v163, v6 offset:57856
  ds_read_u16 v148, v6 offset:51200
  ds_read_u16 v156, v6 offset:54784
  ds_read_u16 v164, v6 offset:58368
  ds_read_u16 v149, v6 offset:51712
  ds_read_u16 v157, v6 offset:55296
  ds_read_u16 v165, v6 offset:58880
  ds_read_u16 v150, v6 offset:52224
  ds_read_u16 v158, v6 offset:55808
  ds_read_u16 v166, v6 offset:59392
  v_mov_b32 v151, 0
  v_mov_b32 v159, 0
  v_mov_b32 v167, 0
  v_mov_b32 v188, s48
  v_mov_b32 v189, s48
  s_waitcnt lgkmcnt(0)
  v_lshlrev_b32 v144, 16, v144
  v_lshlrev_b32 v152, 16, v152
  v_lshlrev_b32 v160, 16, v160
  v_lshlrev_b32 v145, 16, v145
  v_lshlrev_b32 v153, 16, v153
  v_lshlrev_b32 v161, 16, v161
  v_lshlrev_b32 v146, 16, v146
  v_lshlrev_b32 v154, 16, v154
  v_lshlrev_b32 v162, 16, v162
  v_lshlrev_b32 v147, 16, v147
  v_lshlrev_b32 v155, 16, v155
  v_lshlrev_b32 v163, 16, v163
  v_lshlrev_b32 v148, 16, v148
  v_lshlrev_b32 v156, 16, v156
  v_lshlrev_b32 v164, 16, v164
  v_lshlrev_b32 v149, 16, v149
  v_lshlrev_b32 v157, 16, v157
  v_lshlrev_b32 v165, 16, v165
  v_lshlrev_b32 v150, 16, v150
  v_lshlrev_b32 v158, 16, v158
  v_lshlrev_b32 v166, 16, v166
HLOOP:
  s_barrier
  v_mov_b32 v6, 0xeb80
  s_barrier
  ds_read_b64 v[210:211], v6
  s_waitcnt lgkmcnt(0)
  v_pk_mul_f32 v[216:217], v[144:145], v[210:211] op_sel:[0,1] op_sel_hi:[1,1]
  v_cvt_pk_bf16_f32 v220, v216, v217
  v_lshlrev_b32 v216, 16, v220
  v_and_b32 v217, 0xffff0000, v220
  v_pk_add_f32 v[216:217], v[216:217], v[152:153]
  v_cvt_pk_bf16_f32 v220, v216, v217
  v_lshlrev_b32 v216, 16, v220
  v_and_b32 v217, 0xffff0000, v220
  v_pk_mul_f32 v[218:219], v[216:217], v[216:217]
  v_pk_fma_f32 v[218:219], v[218:219], s[50:51], v[188:189] op_sel_hi:[1,0,1]
  v_pk_mul_f32 v[218:219], v[218:219], v[216:217]
  v_exp_f32 v218, v218
  v_exp_f32 v219, v219
  s_nop 0
  v_pk_add_f32 v[218:219], v[218:219], 1.0 op_sel_hi:[1,0]
  v_rcp_f32 v218, v218
  v_rcp_f32 v219, v219
  s_nop 0
  v_pk_mul_f32 v[216:217], v[216:217], v[218:219]
  v_cvt_pk_bf16_f32 v220, v216, v217
  v_lshlrev_b32 v216, 16, v220
  v_and_b32 v217, 0xffff0000, v220
  v_pk_mul_f32 v[214:215], v[216:217], v[160:161]
  v_pk_mul_f32 v[216:217], v[146:147], v[210:211] op_sel:[0,1] op_sel_hi:[1,1]
  v_cvt_pk_bf16_f32 v220, v216, v217
  v_lshlrev_b32 v216, 16, v220
  v_and_b32 v217, 0xffff0000, v220
  v_pk_add_f32 v[216:217], v[216:217], v[154:155]
  v_cvt_pk_bf16_f32 v220, v216, v217
  v_lshlrev_b32 v216, 16, v220
  v_and_b32 v217, 0xffff0000, v220
  v_pk_mul_f32 v[218:219], v[216:217], v[216:217]
  v_pk_fma_f32 v[218:219], v[218:219], s[50:51], v[188:189] op_sel_hi:[1,0,1]
  v_pk_mul_f32 v[218:219], v[218:219], v[216:217]
  v_exp_f32 v218, v218
  v_exp_f32 v219, v219
  s_nop 0
  v_pk_add_f32 v[218:219], v[218:219], 1.0 op_sel_hi:[1,0]
  v_rcp_f32 v218, v218
  v_rcp_f32 v219, v219
  s_nop 0
  v_pk_mul_f32 v[216:217], v[216:217], v[218:219]
  v_cvt_pk_bf16_f32 v220, v216, v217
  v_lshlrev_b32 v216, 16, v220
  v_and_b32 v217, 0xffff0000, v220
  v_pk_fma_f32 v[214:215], v[216:217], v[162:163], v[214:215]
  v_pk_mul_f32 v[216:217], v[148:149], v[210:211] op_sel:[0,1] op_sel_hi:[1,1]
  v_cvt_pk_bf16_f32 v220, v216, v217
  v_lshlrev_b32 v216, 16, v220
  v_and_b32 v217, 0xffff0000, v220
  v_pk_add_f32 v[216:217], v[216:217], v[156:157]
  v_cvt_pk_bf16_f32 v220, v216, v217
  v_lshlrev_b32 v216, 16, v220
  v_and_b32 v217, 0xffff0000, v220
  v_pk_mul_f32 v[218:219], v[216:217], v[216:217]
  v_pk_fma_f32 v[218:219], v[218:219], s[50:51], v[188:189] op_sel_hi:[1,0,1]
  v_pk_mul_f32 v[218:219], v[218:219], v[216:217]
  v_exp_f32 v218, v218
  v_exp_f32 v219, v219
  s_nop 0
  v_pk_add_f32 v[218:219], v[218:219], 1.0 op_sel_hi:[1,0]
  v_rcp_f32 v218, v218
  v_rcp_f32 v219, v219
  s_nop 0
  v_pk_mul_f32 v[216:217], v[216:217], v[218:219]
  v_cvt_pk_bf16_f32 v220, v216, v217
  v_lshlrev_b32 v216, 16, v220
  v_and_b32 v217, 0xffff0000, v220
  v_pk_fma_f32 v[214:215], v[216:217], v[164:165], v[214:215]
  v_pk_mul_f32 v[216:217], v[150:151], v[210:211] op_sel:[0,1] op_sel_hi:[1,1]
  v_cvt_pk_bf16_f32 v220, v216, v217
  v_lshlrev_b32 v216, 16, v220
  v_and_b32 v217, 0xffff0000, v220
  v_pk_add_f32 v[216:217], v[216:217], v[158:159]
  v_cvt_pk_bf16_f32 v220, v216, v217
  v_lshlrev_b32 v216, 16, v220
  v_and_b32 v217, 0xffff0000, v220
  v_pk_mul_f32 v[218:219], v[216:217], v[216:217]
  v_pk_fma_f32 v[218:219], v[218:219], s[50:51], v[188:189] op_sel_hi:[1,0,1]
  v_pk_mul_f32 v[218:219], v[218:219], v[216:217]
  v_exp_f32 v218, v218
  v_exp_f32 v219, v219
  s_nop 0
  v_pk_add_f32 v[218:219], v[218:219], 1.0 op_sel_hi:[1,0]
  v_rcp_f32 v218, v218
  v_rcp_f32 v219, v219
  s_nop 0
  v_pk_mul_f32 v[216:217], v[216:217], v[218:219]
  v_cvt_pk_bf16_f32 v220, v216, v217
  v_lshlrev_b32 v216, 16, v220
  v_and_b32 v217, 0xffff0000, v220
  v_pk_fma_f32 v[214:215], v[216:217], v[166:167], v[214:215]
  v_add_f32 v214, v214, v215
  s_nop 1
  v_add_f32_dpp v214, v214, v214 row_ror:1 row_mask:0xf bank_mask:0xf
  s_nop 1
  v_add_f32_dpp v214, v214, v214 row_ror:2 row_mask:0xf bank_mask:0xf
  s_nop 1
  v_add_f32_dpp v214, v214, v214 row_ror:4 row_mask:0xf bank_mask:0xf
  s_nop 1
  v_add_f32_dpp v214, v214, v214 row_ror:8 row_mask:0xf bank_mask:0xf
  v_mov_b32 v216, v214
  s_nop 1
  v_permlane16_swap_b32 v214, v216
  v_add_f32 v214, v214, v216
  v_mov_b32 v216, v214
  s_nop 1
  v_permlane32_swap_b32 v214, v216
  v_add_f32 v214, v214, v216
  s_lshl_b32 s8, s4, 2
  s_add_u32 s8, s8, 0xeb10
  v_mov_b32 v6, s8
  s_mov_b64 s[14:15], exec
  s_mov_b64 exec, 0x1
  ds_write_b32 v6, v214
  s_mov_b64 exec, s[14:15]
  s_waitcnt lgkmcnt(0)
  s_barrier
  s_cmp_lg_u32 s42, 0
  s_cbranch_scc1 END
  s_mov_b32 s42, 1
  s_barrier
  s_barrier
  s_barrier
  s_branch HLOOP
END:
  s_endpgm
.section .rodata,"a"
.p2align 6
.amdhsa_kernel interleave_layers__sliding_block_cached__mixer_token_mlp__decode_kernel
  .amdhsa_next_free_vgpr 256
  .amdhsa_next_free_sgpr 102
  .amdhsa_accum_offset 256
  .amdhsa_group_segment_fixed_size 0
  .amdhsa_kernarg_size 104
  .amdhsa_user_sgpr_count 2
  .amdhsa_user_sgpr_kernarg_segment_ptr 1
  .amdhsa_system_sgpr_workgroup_id_x 1
  .amdhsa_float_denorm_mode_32 3
.end_amdhsa_kernel
```
